```python
import torch

def _softmax(x, axis=-1):
    return torch.softmax(x, dim=axis)
def _gelu(x):
    return torch.nn.functional.gelu(x, approximate="tanh")
def _silu(x):
    return torch.nn.functional.silu(x)
def _sigmoid(x):
    return torch.sigmoid(x)
def _layernorm(x, axis=-1, eps=1e-5):
    m = x.mean(dim=axis, keepdim=True)
    v = x.var(dim=axis, keepdim=True, unbiased=False)
    return (x - m) / torch.sqrt(v + eps)
def _scatter_add(tgt, idx, src, axis=0):
    return tgt.clone().index_add_(axis, idx, src)
def _segment_sum(src, seg, n):
    out = torch.zeros((n,) + src.shape[1:], dtype=src.dtype)
    return out.index_add_(0, seg, src)
def _pad(x, pw):
    flat = tuple(v for pair in reversed(pw) for v in pair)
    return torch.nn.functional.pad(x, flat)

kernel_name = 'standalone__self_sup_conv_stem_wavlm__speech'

def setup_inputs():

    _w = (lambda a: (lambda t: t.to(torch.bfloat16) if t.is_floating_point() else t)(torch.as_tensor(a)))
    B, T, D, K = 2, 16000, 256, 3
    scale = (K * D) ** -0.5
    return {
        "x": _w((lambda *s: torch.randn(*s, dtype=torch.bfloat16) * 0.05)(B, T, D)),
        "w": _w((lambda *s: torch.randn(*s, dtype=torch.bfloat16) * 0.05)(K, D, D) * scale),
        "gn_gamma": _w((lambda *s: torch.randn(*s, dtype=torch.bfloat16) * 0.05)(D) * 0.1 + 1.0),
        "gn_beta": _w((lambda *s: torch.randn(*s, dtype=torch.bfloat16) * 0.05)(D) * 0.1),
    }

def reference(x, w, gn_gamma, gn_beta):
    B, T, D = x.shape
    K = w.shape[0]
    s = 2
    L = (T - K) // s + 1
    h = torch.einsum('blc,cd->bld', x[:, 0:s * L:s, :], w[0])
    for i in range(1, K):
        h = h + torch.einsum('blc,cd->bld', x[:, i:i + s * L:s, :], w[i])
    mu = torch.einsum('bld->bd', h)[:, None, :] / L
    var = torch.einsum('bld->bd', (h - mu) ** 2)[:, None, :] / L
    h = (h - mu) / torch.sqrt(var + 1e-5)
    h = h * gn_gamma[None, None, :] + gn_beta[None, None, :]
    return _gelu(h)
```

```asm
; @launch grid=(256,1,1) block=(512,1,1) lds=163840
.amdgcn_target "amdgcn-amd-amdhsa--gfx950"
.text
.globl standalone__self_sup_conv_stem_wavlm__speech_kernel
.p2align 8
.type standalone__self_sup_conv_stem_wavlm__speech_kernel,@function
standalone__self_sup_conv_stem_wavlm__speech_kernel:
    s_cmp_ge_u32 s2, 256
    s_cbranch_scc1 L_end
    s_load_dwordx8 s[4:11], s[0:1], 0
    s_load_dwordx4 s[12:15], s[0:1], 32
    s_load_dwordx2 s[16:17], s[0:1], 48
    s_and_b32 s50, s2, 7
    s_lshr_b32 s51, s2, 3
    s_and_b32 s52, s51, 1
    s_lshr_b32 s53, s51, 1
    s_lshl_b32 s53, s53, 3
    s_add_u32 s53, s53, s50
    s_cmp_lt_u32 s53, 2
    s_cbranch_scc1 L_armer
    s_sub_u32 s53, s53, 2
    s_cmp_ge_u32 s53, 63
    s_cselect_b32 s54, 1, 0
    s_mul_i32 s55, s54, 63
    s_sub_u32 s55, s53, s55
    v_lshrrev_b32 v1, 6, v0
    v_and_b32 v2, 63, v0
    v_readfirstlane_b32 s56, v1
    s_mul_i32 s57, s54, 16000
    s_mul_i32 s62, s55, 254
    s_add_u32 s57, s57, s62
    s_lshl_b32 s57, s57, 9
    s_mul_i32 s58, s54, 7999
    s_mul_i32 s62, s55, 127
    s_add_u32 s58, s58, s62
    s_lshl_b32 s58, s58, 9
    s_lshl_b32 s63, s52, 8
    s_add_u32 s58, s58, s63
    s_sub_u32 s59, 7999, s62
    s_min_u32 s59, s59, 127
    s_lshl_b32 s60, s54, 1
    s_add_u32 s60, s60, s52
    s_cmp_lt_u32 s56, 4
    s_cbranch_scc1 L_compute
    s_setprio 3
    s_sub_u32 s65, s56, 4
    v_lshrrev_b32 v3, 3, v2
    s_lshl_b32 s62, s65, 5
    v_add_u32 v3, s62, v3
    v_lshlrev_b32 v3, 10, v3
    v_lshrrev_b32 v4, 4, v2
    v_bfe_u32 v5, v2, 4, 2
    v_lshlrev_b32 v5, 1, v5
    v_and_b32 v6, 7, v2
    v_xor_b32 v5, v5, v6
    v_lshl_add_u32 v16, v5, 4, v3
    v_add_u32 v17, 7168, v16
    v_add_u32 v18, 14336, v16
    v_add_u32 v19, 21504, v16
    s_lshl_b32 s62, s65, 4
    v_add_u32 v3, s62, v4
    v_lshlrev_b32 v3, 9, v3
    v_lshlrev_b32 v5, 1, v4
    v_and_b32 v6, 15, v2
    v_xor_b32 v5, v5, v6
    v_lshl_add_u32 v3, v5, 4, v3
    s_lshl_b32 s62, s52, 8
    v_add_u32 v20, s62, v3
    v_add_u32 v21, 1024, v20
    v_xor_b32 v22, 128, v20
    v_add_u32 v23, 3072, v22
    v_add_u32 v22, 2048, v22
    s_lshl_b32 s67, s65, 12
    s_add_u32 s86, s67, 0x10000
    s_lshl_b32 s90, s52, 14
    s_xor_b32 s91, s90, 0x4000
    s_lshl_b32 s92, s52, 9
    s_xor_b32 s93, s92, 0x200
    s_cmp_eq_u32 s52, 0
    s_cselect_b32 s68, 0, 131072
    s_cselect_b32 s69, 262144, 0
    s_cselect_b32 s70, 1, 2
    s_lshl_b32 s70, s70, 17
    s_lshr_b32 s89, s51, 1
    s_mov_b32 s61, 0
    s_waitcnt lgkmcnt(0)
    s_mov_b32 s20, s4
    s_and_b32 s21, s5, 0xffff
    s_mov_b32 s22, 16384000
    s_mov_b32 s23, 0x00020000
    s_mov_b32 s24, s6
    s_and_b32 s25, s7, 0xffff
    s_mov_b32 s26, 393216
    s_mov_b32 s27, 0x00020000
L_lloop:
    s_add_u32 s63, s89, s61
    s_and_b32 s63, s63, 3
    s_lshl_b32 s88, s63, 15
    s_lshl_b32 s63, s63, 7
    s_add_u32 s87, s57, s63
    s_add_u32 m0, s67, s90
    s_add_u32 s62, s87, s92
    buffer_load_dwordx4 v16, s[20:23], s62 offen offset:0 lds
    buffer_load_dwordx4 v17, s[20:23], s62 offen offset:1024 lds
    buffer_load_dwordx4 v18, s[20:23], s62 offen offset:2048 lds
    buffer_load_dwordx4 v19, s[20:23], s62 offen offset:3072 lds
    s_add_u32 m0, s86, 0
    s_add_u32 s62, s88, s68
    buffer_load_dwordx4 v20, s[24:27], s62 offen offset:0 lds
    buffer_load_dwordx4 v21, s[24:27], s62 offen offset:1024 lds
    buffer_load_dwordx4 v22, s[24:27], s62 offen offset:2048 lds
    buffer_load_dwordx4 v23, s[24:27], s62 offen offset:3072 lds
    s_add_u32 m0, s67, s91
    s_add_u32 s62, s87, s93
    buffer_load_dwordx4 v16, s[20:23], s62 offen offset:0 lds
    buffer_load_dwordx4 v17, s[20:23], s62 offen offset:1024 lds
    buffer_load_dwordx4 v18, s[20:23], s62 offen offset:2048 lds
    buffer_load_dwordx4 v19, s[20:23], s62 offen offset:3072 lds
    s_cmp_eq_u32 s61, 0
    s_cbranch_scc1 L_ls1
    s_waitcnt vmcnt(16)
    s_barrier
L_ls1:
    s_add_u32 m0, s86, 16384
    s_add_u32 s62, s88, s69
    buffer_load_dwordx4 v20, s[24:27], s62 offen offset:0 lds
    buffer_load_dwordx4 v21, s[24:27], s62 offen offset:1024 lds
    buffer_load_dwordx4 v22, s[24:27], s62 offen offset:2048 lds
    buffer_load_dwordx4 v23, s[24:27], s62 offen offset:3072 lds
    s_cmp_eq_u32 s61, 0
    s_cbranch_scc1 L_ls2
    s_waitcnt vmcnt(16)
    s_barrier
L_ls2:
    s_add_u32 m0, s86, 32768
    s_add_u32 s62, s88, s70
    buffer_load_dwordx4 v20, s[24:27], s62 offen offset:0 lds
    buffer_load_dwordx4 v21, s[24:27], s62 offen offset:1024 lds
    buffer_load_dwordx4 v22, s[24:27], s62 offen offset:2048 lds
    buffer_load_dwordx4 v23, s[24:27], s62 offen offset:3072 lds
    s_xor_b32 s67, s67, 0x8000
    s_xor_b32 s86, s86, 0xc000
    s_add_u32 s61, s61, 1
    s_cmp_lt_u32 s61, 4
    s_waitcnt vmcnt(12)
    s_barrier
    s_cbranch_scc1 L_lloop
    s_mov_b32 s40, s8
    s_and_b32 s41, s9, 0xffff
    s_mov_b32 s42, 512
    s_mov_b32 s43, 0x00020000
    s_mov_b32 s44, s10
    s_and_b32 s45, s11, 0xffff
    s_mov_b32 s46, 512
    s_mov_b32 s47, 0x00020000
    s_mov_b32 s28, s12
    s_and_b32 s29, s13, 0xffff
    s_mov_b32 s30, 8190976
    s_mov_b32 s31, 0x00020000
    s_mov_b32 s36, s14
    s_and_b32 s37, s15, 0xffff
    s_mov_b32 s38, 256
    s_mov_b32 s39, 0x00020000
    s_lshl_b32 s62, s60, 16
    s_add_u32 s32, s16, s62
    s_addc_u32 s33, s17, 0
    s_and_b32 s33, s33, 0xffff
    s_mov_b32 s34, 64512
    s_mov_b32 s35, 0x00020000
    v_and_b32 v29, 7, v2
    s_lshl_b32 s62, s56, 5
    v_lshl_add_u32 v29, v29, 2, s62
    s_lshl_b32 s62, s52, 8
    buffer_load_dword v30, v29, s[40:43], s62 offen
    buffer_load_dword v31, v29, s[44:47], s62 offen
    s_lshl_b32 s62, s60, 6
    v_mov_b32 v24, s62
    buffer_load_dword v5, v24, s[36:39], 0 offen sc1
    s_waitcnt vmcnt(7)
    s_barrier
    s_waitcnt vmcnt(3)
    s_barrier
L_ljoin:
    s_setprio 0
    s_barrier
    s_mov_b32 s72, 0
    s_waitcnt vmcnt(0)
L_flagpoll:
    v_cmp_eq_u32 vcc, 0, v5
    s_add_u32 s72, s72, 1
    s_cmp_ge_u32 s72, 0x40000
    s_cbranch_scc1 L_noflagwait
    s_cbranch_vccz L_noflagwait
    s_sleep 16
    buffer_load_dword v5, v24, s[36:39], 0 offen sc1
    s_waitcnt vmcnt(0)
    s_branch L_flagpoll
L_noflagwait:
    s_barrier
    s_branch L_join
L_compute:
    s_lshr_b32 s62, s56, 1
    s_and_b32 s63, s56, 1
    s_lshl_b32 s64, s62, 6
    v_and_b32 v3, 15, v2
    v_lshrrev_b32 v8, 4, v2
    v_add_u32 v9, s64, v3
    v_and_b32 v10, 6, v9
    v_xor_b32 v10, v10, v8
    v_lshlrev_b32 v10, 4, v10
    v_lshl_add_u32 v4, v9, 7, v10
    v_add_u32 v9, 1, v9
    v_and_b32 v10, 6, v9
    v_xor_b32 v10, v10, v8
    v_lshlrev_b32 v10, 4, v10
    v_lshl_add_u32 v5, v9, 7, v10
    v_add_u32 v6, 0x4000, v4
    s_cmp_eq_u32 s52, 0
    s_cselect_b64 vcc, -1, 0
    v_cndmask_b32 v12, v6, v4, vcc
    v_cndmask_b32 v14, v4, v5, vcc
    v_cndmask_b32 v16, v5, v6, vcc
    v_xor_b32 v13, 64, v12
    v_xor_b32 v15, 64, v14
    v_xor_b32 v17, 64, v16
    v_bfe_u32 v9, v2, 2, 2
    v_lshl_add_u32 v10, v8, 3, v9
    v_lshlrev_b32 v10, 8, v10
    v_and_b32 v11, 3, v2
    v_lshl_add_u32 v10, v11, 3, v10
    v_and_b32 v11, 1, v8
    v_lshl_or_b32 v11, v11, 2, v9
    s_lshl_b32 s64, s63, 2
    v_xor_b32 v11, s64, v11
    v_lshl_add_u32 v10, v11, 5, v10
    v_add_u32 v20, 0x10000, v10
    v_xor_b32 v21, 32, v20
    v_xor_b32 v22, 64, v20
    v_xor_b32 v23, 96, v20
    v_mov_b32 v64, 0
    v_mov_b32 v65, 0
    v_mov_b32 v66, 0
    v_mov_b32 v67, 0
    v_mov_b32 v68, 0
    v_mov_b32 v69, 0
    v_mov_b32 v70, 0
    v_mov_b32 v71, 0
    v_mov_b32 v72, 0
    v_mov_b32 v73, 0
    v_mov_b32 v74, 0
    v_mov_b32 v75, 0
    v_mov_b32 v76, 0
    v_mov_b32 v77, 0
    v_mov_b32 v78, 0
    v_mov_b32 v79, 0
    v_mov_b32 v80, 0
    v_mov_b32 v81, 0
    v_mov_b32 v82, 0
    v_mov_b32 v83, 0
    v_mov_b32 v84, 0
    v_mov_b32 v85, 0
    v_mov_b32 v86, 0
    v_mov_b32 v87, 0
    v_mov_b32 v88, 0
    v_mov_b32 v89, 0
    v_mov_b32 v90, 0
    v_mov_b32 v91, 0
    v_mov_b32 v92, 0
    v_mov_b32 v93, 0
    v_mov_b32 v94, 0
    v_mov_b32 v95, 0
    v_mov_b32 v96, 0
    v_mov_b32 v97, 0
    v_mov_b32 v98, 0
    v_mov_b32 v99, 0
    v_mov_b32 v100, 0
    v_mov_b32 v101, 0
    v_mov_b32 v102, 0
    v_mov_b32 v103, 0
    v_mov_b32 v104, 0
    v_mov_b32 v105, 0
    v_mov_b32 v106, 0
    v_mov_b32 v107, 0
    v_mov_b32 v108, 0
    v_mov_b32 v109, 0
    v_mov_b32 v110, 0
    v_mov_b32 v111, 0
    v_mov_b32 v112, 0
    v_mov_b32 v113, 0
    v_mov_b32 v114, 0
    v_mov_b32 v115, 0
    v_mov_b32 v116, 0
    v_mov_b32 v117, 0
    v_mov_b32 v118, 0
    v_mov_b32 v119, 0
    v_mov_b32 v120, 0
    v_mov_b32 v121, 0
    v_mov_b32 v122, 0
    v_mov_b32 v123, 0
    v_mov_b32 v124, 0
    v_mov_b32 v125, 0
    v_mov_b32 v126, 0
    v_mov_b32 v127, 0
    s_waitcnt lgkmcnt(0)
    s_mov_b32 s40, s8
    s_and_b32 s41, s9, 0xffff
    s_mov_b32 s42, 512
    s_mov_b32 s43, 0x00020000
    s_mov_b32 s44, s10
    s_and_b32 s45, s11, 0xffff
    s_mov_b32 s46, 512
    s_mov_b32 s47, 0x00020000
    s_mov_b32 s28, s12
    s_and_b32 s29, s13, 0xffff
    s_mov_b32 s30, 8190976
    s_mov_b32 s31, 0x00020000
    s_mov_b32 s36, s14
    s_and_b32 s37, s15, 0xffff
    s_mov_b32 s38, 256
    s_mov_b32 s39, 0x00020000
    s_lshl_b32 s62, s60, 16
    s_add_u32 s32, s16, s62
    s_addc_u32 s33, s17, 0
    s_and_b32 s33, s33, 0xffff
    s_mov_b32 s34, 64512
    s_mov_b32 s35, 0x00020000
    v_and_b32 v29, 7, v2
    s_lshl_b32 s62, s56, 5
    v_lshl_add_u32 v29, v29, 2, s62
    s_lshl_b32 s62, s52, 8
    buffer_load_dword v30, v29, s[40:43], s62 offen
    buffer_load_dword v31, v29, s[44:47], s62 offen
    s_mov_b32 s61, 0
    s_barrier
    ds_read_b128 v[32:35], v12 offset:0
    ds_read_b64_tr_b16 v[48:49], v20 offset:0
    ds_read_b64_tr_b16 v[50:51], v20 offset:1024
    ds_read_b64_tr_b16 v[52:53], v21 offset:0
    ds_read_b64_tr_b16 v[54:55], v21 offset:1024
    ds_read_b128 v[36:39], v12 offset:2048
    ds_read_b64_tr_b16 v[56:57], v22 offset:0
    ds_read_b64_tr_b16 v[58:59], v22 offset:1024
    ds_read_b64_tr_b16 v[60:61], v23 offset:0
    ds_read_b64_tr_b16 v[62:63], v23 offset:1024
    ds_read_b128 v[40:43], v12 offset:4096
    ds_read_b128 v[44:47], v12 offset:6144
L_loop:
    s_waitcnt lgkmcnt(9)
    v_mfma_f32_16x16x32_bf16 v[64:67], v[32:35], v[48:51], v[64:67]
    ds_read_b128 v[128:131], v13 offset:0
    s_waitcnt lgkmcnt(8)
    v_mfma_f32_16x16x32_bf16 v[68:71], v[32:35], v[52:55], v[68:71]
    ds_read_b64_tr_b16 v[144:145], v20 offset:8192
    s_waitcnt lgkmcnt(8)
    v_mfma_f32_16x16x32_bf16 v[80:83], v[36:39], v[48:51], v[80:83]
    ds_read_b64_tr_b16 v[146:147], v20 offset:9216
    v_mfma_f32_16x16x32_bf16 v[84:87], v[36:39], v[52:55], v[84:87]
    ds_read_b64_tr_b16 v[148:149], v21 offset:8192
    s_waitcnt lgkmcnt(8)
    v_mfma_f32_16x16x32_bf16 v[72:75], v[32:35], v[56:59], v[72:75]
    ds_read_b64_tr_b16 v[150:151], v21 offset:9216
    s_waitcnt lgkmcnt(7)
    v_mfma_f32_16x16x32_bf16 v[76:79], v[32:35], v[60:63], v[76:79]
    ds_read_b128 v[132:135], v13 offset:2048
    v_mfma_f32_16x16x32_bf16 v[88:91], v[36:39], v[56:59], v[88:91]
    ds_read_b64_tr_b16 v[152:153], v22 offset:8192
    v_mfma_f32_16x16x32_bf16 v[92:95], v[36:39], v[60:63], v[92:95]
    ds_read_b64_tr_b16 v[154:155], v22 offset:9216
    s_waitcnt lgkmcnt(9)
    v_mfma_f32_16x16x32_bf16 v[96:99], v[40:43], v[48:51], v[96:99]
    ds_read_b64_tr_b16 v[156:157], v23 offset:8192
    v_mfma_f32_16x16x32_bf16 v[100:103], v[40:43], v[52:55], v[100:103]
    ds_read_b64_tr_b16 v[158:159], v23 offset:9216
    v_mfma_f32_16x16x32_bf16 v[104:107], v[40:43], v[56:59], v[104:107]
    ds_read_b128 v[136:139], v13 offset:4096
    v_mfma_f32_16x16x32_bf16 v[108:111], v[40:43], v[60:63], v[108:111]
    ds_read_b128 v[140:143], v13 offset:6144
    s_waitcnt lgkmcnt(12)
    v_mfma_f32_16x16x32_bf16 v[112:115], v[44:47], v[48:51], v[112:115]
    v_mfma_f32_16x16x32_bf16 v[116:119], v[44:47], v[52:55], v[116:119]
    v_mfma_f32_16x16x32_bf16 v[120:123], v[44:47], v[56:59], v[120:123]
    v_mfma_f32_16x16x32_bf16 v[124:127], v[44:47], v[60:63], v[124:127]
    s_waitcnt lgkmcnt(9)
    v_mfma_f32_16x16x32_bf16 v[64:67], v[128:131], v[144:147], v[64:67]
    s_waitcnt lgkmcnt(7)
    v_mfma_f32_16x16x32_bf16 v[68:71], v[128:131], v[148:151], v[68:71]
    s_waitcnt lgkmcnt(6)
    v_mfma_f32_16x16x32_bf16 v[80:83], v[132:135], v[144:147], v[80:83]
    v_mfma_f32_16x16x32_bf16 v[84:87], v[132:135], v[148:151], v[84:87]
    s_waitcnt lgkmcnt(0)
    s_barrier
    ds_read_b128 v[32:35], v14 offset:0
    v_mfma_f32_16x16x32_bf16 v[72:75], v[128:131], v[152:155], v[72:75]
    ds_read_b64_tr_b16 v[48:49], v20 offset:16384
    v_mfma_f32_16x16x32_bf16 v[76:79], v[128:131], v[156:159], v[76:79]
    ds_read_b64_tr_b16 v[50:51], v20 offset:17408
    v_mfma_f32_16x16x32_bf16 v[88:91], v[132:135], v[152:155], v[88:91]
    ds_read_b64_tr_b16 v[52:53], v21 offset:16384
    v_mfma_f32_16x16x32_bf16 v[92:95], v[132:135], v[156:159], v[92:95]
    ds_read_b64_tr_b16 v[54:55], v21 offset:17408
    v_mfma_f32_16x16x32_bf16 v[96:99], v[136:139], v[144:147], v[96:99]
    ds_read_b128 v[36:39], v14 offset:2048
    v_mfma_f32_16x16x32_bf16 v[100:103], v[136:139], v[148:151], v[100:103]
    ds_read_b64_tr_b16 v[56:57], v22 offset:16384
    v_mfma_f32_16x16x32_bf16 v[104:107], v[136:139], v[152:155], v[104:107]
    ds_read_b64_tr_b16 v[58:59], v22 offset:17408
    v_mfma_f32_16x16x32_bf16 v[108:111], v[136:139], v[156:159], v[108:111]
    ds_read_b64_tr_b16 v[60:61], v23 offset:16384
    v_mfma_f32_16x16x32_bf16 v[112:115], v[140:143], v[144:147], v[112:115]
    ds_read_b64_tr_b16 v[62:63], v23 offset:17408
    v_mfma_f32_16x16x32_bf16 v[116:119], v[140:143], v[148:151], v[116:119]
    ds_read_b128 v[40:43], v14 offset:4096
    v_mfma_f32_16x16x32_bf16 v[120:123], v[140:143], v[152:155], v[120:123]
    ds_read_b128 v[44:47], v14 offset:6144
    v_mfma_f32_16x16x32_bf16 v[124:127], v[140:143], v[156:159], v[124:127]
    s_waitcnt lgkmcnt(9)
    v_mfma_f32_16x16x32_bf16 v[64:67], v[32:35], v[48:51], v[64:67]
    ds_read_b128 v[128:131], v15 offset:0
    s_waitcnt lgkmcnt(8)
    v_mfma_f32_16x16x32_bf16 v[68:71], v[32:35], v[52:55], v[68:71]
    ds_read_b64_tr_b16 v[144:145], v20 offset:24576
    s_waitcnt lgkmcnt(8)
    v_mfma_f32_16x16x32_bf16 v[80:83], v[36:39], v[48:51], v[80:83]
    ds_read_b64_tr_b16 v[146:147], v20 offset:25600
    v_mfma_f32_16x16x32_bf16 v[84:87], v[36:39], v[52:55], v[84:87]
    ds_read_b64_tr_b16 v[148:149], v21 offset:24576
    s_waitcnt lgkmcnt(8)
    v_mfma_f32_16x16x32_bf16 v[72:75], v[32:35], v[56:59], v[72:75]
    ds_read_b64_tr_b16 v[150:151], v21 offset:25600
    s_waitcnt lgkmcnt(7)
    v_mfma_f32_16x16x32_bf16 v[76:79], v[32:35], v[60:63], v[76:79]
    ds_read_b128 v[132:135], v15 offset:2048
    v_mfma_f32_16x16x32_bf16 v[88:91], v[36:39], v[56:59], v[88:91]
    ds_read_b64_tr_b16 v[152:153], v22 offset:24576
    v_mfma_f32_16x16x32_bf16 v[92:95], v[36:39], v[60:63], v[92:95]
    ds_read_b64_tr_b16 v[154:155], v22 offset:25600
    s_waitcnt lgkmcnt(9)
    v_mfma_f32_16x16x32_bf16 v[96:99], v[40:43], v[48:51], v[96:99]
    ds_read_b64_tr_b16 v[156:157], v23 offset:24576
    v_mfma_f32_16x16x32_bf16 v[100:103], v[40:43], v[52:55], v[100:103]
    ds_read_b64_tr_b16 v[158:159], v23 offset:25600
    v_mfma_f32_16x16x32_bf16 v[104:107], v[40:43], v[56:59], v[104:107]
    ds_read_b128 v[136:139], v15 offset:4096
    v_mfma_f32_16x16x32_bf16 v[108:111], v[40:43], v[60:63], v[108:111]
    ds_read_b128 v[140:143], v15 offset:6144
    s_waitcnt lgkmcnt(12)
    v_mfma_f32_16x16x32_bf16 v[112:115], v[44:47], v[48:51], v[112:115]
    v_mfma_f32_16x16x32_bf16 v[116:119], v[44:47], v[52:55], v[116:119]
    v_xor_b32 v12, 0x8000, v12
    v_xor_b32 v13, 0x8000, v13
    v_mfma_f32_16x16x32_bf16 v[120:123], v[44:47], v[56:59], v[120:123]
    v_mfma_f32_16x16x32_bf16 v[124:127], v[44:47], v[60:63], v[124:127]
    s_waitcnt lgkmcnt(9)
    v_mfma_f32_16x16x32_bf16 v[64:67], v[128:131], v[144:147], v[64:67]
    s_waitcnt lgkmcnt(7)
    v_mfma_f32_16x16x32_bf16 v[68:71], v[128:131], v[148:151], v[68:71]
    s_waitcnt lgkmcnt(6)
    v_mfma_f32_16x16x32_bf16 v[80:83], v[132:135], v[144:147], v[80:83]
    v_mfma_f32_16x16x32_bf16 v[84:87], v[132:135], v[148:151], v[84:87]
    s_waitcnt lgkmcnt(0)
    s_barrier
    ds_read_b128 v[32:35], v16 offset:0
    v_mfma_f32_16x16x32_bf16 v[72:75], v[128:131], v[152:155], v[72:75]
    ds_read_b64_tr_b16 v[48:49], v20 offset:32768
    v_mfma_f32_16x16x32_bf16 v[76:79], v[128:131], v[156:159], v[76:79]
    ds_read_b64_tr_b16 v[50:51], v20 offset:33792
    v_mfma_f32_16x16x32_bf16 v[88:91], v[132:135], v[152:155], v[88:91]
    ds_read_b64_tr_b16 v[52:53], v21 offset:32768
    v_mfma_f32_16x16x32_bf16 v[92:95], v[132:135], v[156:159], v[92:95]
    ds_read_b64_tr_b16 v[54:55], v21 offset:33792
    v_mfma_f32_16x16x32_bf16 v[96:99], v[136:139], v[144:147], v[96:99]
    ds_read_b128 v[36:39], v16 offset:2048
    v_mfma_f32_16x16x32_bf16 v[100:103], v[136:139], v[148:151], v[100:103]
    ds_read_b64_tr_b16 v[56:57], v22 offset:32768
    v_mfma_f32_16x16x32_bf16 v[104:107], v[136:139], v[152:155], v[104:107]
    ds_read_b64_tr_b16 v[58:59], v22 offset:33792
    v_mfma_f32_16x16x32_bf16 v[108:111], v[136:139], v[156:159], v[108:111]
    ds_read_b64_tr_b16 v[60:61], v23 offset:32768
    v_mfma_f32_16x16x32_bf16 v[112:115], v[140:143], v[144:147], v[112:115]
    ds_read_b64_tr_b16 v[62:63], v23 offset:33792
    v_mfma_f32_16x16x32_bf16 v[116:119], v[140:143], v[148:151], v[116:119]
    ds_read_b128 v[40:43], v16 offset:4096
    v_mfma_f32_16x16x32_bf16 v[120:123], v[140:143], v[152:155], v[120:123]
    ds_read_b128 v[44:47], v16 offset:6144
    v_mfma_f32_16x16x32_bf16 v[124:127], v[140:143], v[156:159], v[124:127]
    s_waitcnt lgkmcnt(9)
    v_mfma_f32_16x16x32_bf16 v[64:67], v[32:35], v[48:51], v[64:67]
    ds_read_b128 v[128:131], v17 offset:0
    s_waitcnt lgkmcnt(8)
    v_mfma_f32_16x16x32_bf16 v[68:71], v[32:35], v[52:55], v[68:71]
    ds_read_b64_tr_b16 v[144:145], v20 offset:40960
    s_waitcnt lgkmcnt(8)
    v_mfma_f32_16x16x32_bf16 v[80:83], v[36:39], v[48:51], v[80:83]
    ds_read_b64_tr_b16 v[146:147], v20 offset:41984
    v_mfma_f32_16x16x32_bf16 v[84:87], v[36:39], v[52:55], v[84:87]
    ds_read_b64_tr_b16 v[148:149], v21 offset:40960
    s_waitcnt lgkmcnt(8)
    v_mfma_f32_16x16x32_bf16 v[72:75], v[32:35], v[56:59], v[72:75]
    ds_read_b64_tr_b16 v[150:151], v21 offset:41984
    s_waitcnt lgkmcnt(7)
    v_mfma_f32_16x16x32_bf16 v[76:79], v[32:35], v[60:63], v[76:79]
    ds_read_b128 v[132:135], v17 offset:2048
    v_mfma_f32_16x16x32_bf16 v[88:91], v[36:39], v[56:59], v[88:91]
    ds_read_b64_tr_b16 v[152:153], v22 offset:40960
    v_mfma_f32_16x16x32_bf16 v[92:95], v[36:39], v[60:63], v[92:95]
    ds_read_b64_tr_b16 v[154:155], v22 offset:41984
    s_waitcnt lgkmcnt(9)
    v_mfma_f32_16x16x32_bf16 v[96:99], v[40:43], v[48:51], v[96:99]
    ds_read_b64_tr_b16 v[156:157], v23 offset:40960
    v_mfma_f32_16x16x32_bf16 v[100:103], v[40:43], v[52:55], v[100:103]
    ds_read_b64_tr_b16 v[158:159], v23 offset:41984
    v_mfma_f32_16x16x32_bf16 v[104:107], v[40:43], v[56:59], v[104:107]
    ds_read_b128 v[136:139], v17 offset:4096
    v_mfma_f32_16x16x32_bf16 v[108:111], v[40:43], v[60:63], v[108:111]
    ds_read_b128 v[140:143], v17 offset:6144
    s_waitcnt lgkmcnt(12)
    v_mfma_f32_16x16x32_bf16 v[112:115], v[44:47], v[48:51], v[112:115]
    v_mfma_f32_16x16x32_bf16 v[116:119], v[44:47], v[52:55], v[116:119]
    v_xor_b32 v14, 0x8000, v14
    v_xor_b32 v15, 0x8000, v15
    v_mfma_f32_16x16x32_bf16 v[120:123], v[44:47], v[56:59], v[120:123]
    v_mfma_f32_16x16x32_bf16 v[124:127], v[44:47], v[60:63], v[124:127]
    s_waitcnt lgkmcnt(9)
    v_mfma_f32_16x16x32_bf16 v[64:67], v[128:131], v[144:147], v[64:67]
    s_waitcnt lgkmcnt(7)
    v_mfma_f32_16x16x32_bf16 v[68:71], v[128:131], v[148:151], v[68:71]
    s_waitcnt lgkmcnt(6)
    v_mfma_f32_16x16x32_bf16 v[80:83], v[132:135], v[144:147], v[80:83]
    v_mfma_f32_16x16x32_bf16 v[84:87], v[132:135], v[148:151], v[84:87]
    v_xor_b32 v20, 0xc000, v20
    v_xor_b32 v21, 0xc000, v21
    v_xor_b32 v22, 0xc000, v22
    v_xor_b32 v23, 0xc000, v23
    s_waitcnt lgkmcnt(0)
    s_barrier
    ds_read_b128 v[32:35], v12 offset:0
    v_mfma_f32_16x16x32_bf16 v[72:75], v[128:131], v[152:155], v[72:75]
    ds_read_b64_tr_b16 v[48:49], v20 offset:0
    v_mfma_f32_16x16x32_bf16 v[76:79], v[128:131], v[156:159], v[76:79]
    ds_read_b64_tr_b16 v[50:51], v20 offset:1024
    v_mfma_f32_16x16x32_bf16 v[88:91], v[132:135], v[152:155], v[88:91]
    ds_read_b64_tr_b16 v[52:53], v21 offset:0
    v_mfma_f32_16x16x32_bf16 v[92:95], v[132:135], v[156:159], v[92:95]
    ds_read_b64_tr_b16 v[54:55], v21 offset:1024
    v_mfma_f32_16x16x32_bf16 v[96:99], v[136:139], v[144:147], v[96:99]
    ds_read_b128 v[36:39], v12 offset:2048
    v_mfma_f32_16x16x32_bf16 v[100:103], v[136:139], v[148:151], v[100:103]
    ds_read_b64_tr_b16 v[56:57], v22 offset:0
    v_mfma_f32_16x16x32_bf16 v[104:107], v[136:139], v[152:155], v[104:107]
    ds_read_b64_tr_b16 v[58:59], v22 offset:1024
    v_mfma_f32_16x16x32_bf16 v[108:111], v[136:139], v[156:159], v[108:111]
    ds_read_b64_tr_b16 v[60:61], v23 offset:0
    v_mfma_f32_16x16x32_bf16 v[112:115], v[140:143], v[144:147], v[112:115]
    ds_read_b64_tr_b16 v[62:63], v23 offset:1024
    v_mfma_f32_16x16x32_bf16 v[116:119], v[140:143], v[148:151], v[116:119]
    ds_read_b128 v[40:43], v12 offset:4096
    v_xor_b32 v16, 0x8000, v16
    v_xor_b32 v17, 0x8000, v17
    v_mfma_f32_16x16x32_bf16 v[120:123], v[140:143], v[152:155], v[120:123]
    ds_read_b128 v[44:47], v12 offset:6144
    v_mfma_f32_16x16x32_bf16 v[124:127], v[140:143], v[156:159], v[124:127]
    s_add_u32 s61, s61, 1
    s_cmp_lt_u32 s61, 4
    s_cbranch_scc1 L_loop
L_tail:
    s_lshr_b32 s62, s56, 1
    s_and_b32 s63, s56, 1
    s_lshl_b32 s64, s62, 6
    s_add_u32 s64, s64, 48
    v_lshl_add_u32 v9, v8, 2, s64
    s_lshl_b32 s64, s63, 9
    v_lshl_add_u32 v10, v2, 3, s64
    v_add_u32 v11, 0x10000, v10
    s_waitcnt lgkmcnt(0)
    v_pk_mul_f32 v[34:35], v[64:65], v[64:65]
    v_pk_mul_f32 v[38:39], v[68:69], v[68:69]
    v_pk_mul_f32 v[42:43], v[72:73], v[72:73]
    v_pk_mul_f32 v[46:47], v[76:77], v[76:77]
    v_pk_add_f32 v[32:33], v[64:65], v[66:67]
    v_pk_fma_f32 v[34:35], v[66:67], v[66:67], v[34:35]
    v_pk_add_f32 v[36:37], v[68:69], v[70:71]
    v_pk_fma_f32 v[38:39], v[70:71], v[70:71], v[38:39]
    v_pk_add_f32 v[40:41], v[72:73], v[74:75]
    v_pk_fma_f32 v[42:43], v[74:75], v[74:75], v[42:43]
    v_pk_add_f32 v[44:45], v[76:77], v[78:79]
    v_pk_fma_f32 v[46:47], v[78:79], v[78:79], v[46:47]
    v_pk_add_f32 v[32:33], v[32:33], v[80:81]
    v_pk_fma_f32 v[34:35], v[80:81], v[80:81], v[34:35]
    v_pk_add_f32 v[36:37], v[36:37], v[84:85]
    v_pk_fma_f32 v[38:39], v[84:85], v[84:85], v[38:39]
    v_pk_add_f32 v[40:41], v[40:41], v[88:89]
    v_pk_fma_f32 v[42:43], v[88:89], v[88:89], v[42:43]
    v_pk_add_f32 v[44:45], v[44:45], v[92:93]
    v_pk_fma_f32 v[46:47], v[92:93], v[92:93], v[46:47]
    v_pk_add_f32 v[32:33], v[32:33], v[82:83]
    v_pk_fma_f32 v[34:35], v[82:83], v[82:83], v[34:35]
    v_pk_add_f32 v[36:37], v[36:37], v[86:87]
    v_pk_fma_f32 v[38:39], v[86:87], v[86:87], v[38:39]
    v_pk_add_f32 v[40:41], v[40:41], v[90:91]
    v_pk_fma_f32 v[42:43], v[90:91], v[90:91], v[42:43]
    v_pk_add_f32 v[44:45], v[44:45], v[94:95]
    v_pk_fma_f32 v[46:47], v[94:95], v[94:95], v[46:47]
    v_pk_add_f32 v[32:33], v[32:33], v[96:97]
    v_pk_fma_f32 v[34:35], v[96:97], v[96:97], v[34:35]
    v_pk_add_f32 v[36:37], v[36:37], v[100:101]
    v_pk_fma_f32 v[38:39], v[100:101], v[100:101], v[38:39]
    v_pk_add_f32 v[40:41], v[40:41], v[104:105]
    v_pk_fma_f32 v[42:43], v[104:105], v[104:105], v[42:43]
    v_pk_add_f32 v[44:45], v[44:45], v[108:109]
    v_pk_fma_f32 v[46:47], v[108:109], v[108:109], v[46:47]
    v_pk_add_f32 v[32:33], v[32:33], v[98:99]
    v_pk_fma_f32 v[34:35], v[98:99], v[98:99], v[34:35]
    v_pk_add_f32 v[36:37], v[36:37], v[102:103]
    v_pk_fma_f32 v[38:39], v[102:103], v[102:103], v[38:39]
    v_pk_add_f32 v[40:41], v[40:41], v[106:107]
    v_pk_fma_f32 v[42:43], v[106:107], v[106:107], v[42:43]
    v_pk_add_f32 v[44:45], v[44:45], v[110:111]
    v_pk_fma_f32 v[46:47], v[110:111], v[110:111], v[46:47]
    v_add_u32 v26, 1, v9
    v_cmp_gt_u32 vcc, s59, v26
    s_nop 1
    v_cndmask_b32 v113, 0, v113, vcc
    v_cndmask_b32 v117, 0, v117, vcc
    v_cndmask_b32 v121, 0, v121, vcc
    v_cndmask_b32 v125, 0, v125, vcc
    v_add_u32 v26, 2, v9
    v_cmp_gt_u32 vcc, s59, v26
    s_nop 1
    v_cndmask_b32 v114, 0, v114, vcc
    v_cndmask_b32 v118, 0, v118, vcc
    v_cndmask_b32 v122, 0, v122, vcc
    v_cndmask_b32 v126, 0, v126, vcc
    v_add_u32 v26, 3, v9
    v_cmp_gt_u32 vcc, s59, v26
    s_nop 1
    v_cndmask_b32 v115, 0, v115, vcc
    v_cndmask_b32 v119, 0, v119, vcc
    v_cndmask_b32 v123, 0, v123, vcc
    v_cndmask_b32 v127, 0, v127, vcc
    v_pk_add_f32 v[32:33], v[32:33], v[112:113]
    v_pk_fma_f32 v[34:35], v[112:113], v[112:113], v[34:35]
    v_pk_add_f32 v[36:37], v[36:37], v[116:117]
    v_pk_fma_f32 v[38:39], v[116:117], v[116:117], v[38:39]
    v_pk_add_f32 v[40:41], v[40:41], v[120:121]
    v_pk_fma_f32 v[42:43], v[120:121], v[120:121], v[42:43]
    v_pk_add_f32 v[44:45], v[44:45], v[124:125]
    v_pk_fma_f32 v[46:47], v[124:125], v[124:125], v[46:47]
    v_pk_add_f32 v[32:33], v[32:33], v[114:115]
    v_pk_fma_f32 v[34:35], v[114:115], v[114:115], v[34:35]
    v_pk_add_f32 v[36:37], v[36:37], v[118:119]
    v_pk_fma_f32 v[38:39], v[118:119], v[118:119], v[38:39]
    v_pk_add_f32 v[40:41], v[40:41], v[122:123]
    v_pk_fma_f32 v[42:43], v[122:123], v[122:123], v[42:43]
    v_pk_add_f32 v[44:45], v[44:45], v[126:127]
    v_pk_fma_f32 v[46:47], v[126:127], v[126:127], v[46:47]
    v_add_f32 v48, v32, v33
    v_add_f32 v52, v34, v35
    v_add_f32 v49, v36, v37
    v_add_f32 v53, v38, v39
    v_add_f32 v50, v40, v41
    v_add_f32 v54, v42, v43
    v_add_f32 v51, v44, v45
    v_add_f32 v55, v46, v47
    s_nop 0
    v_permlane32_swap_b32 v48, v50
    v_permlane32_swap_b32 v49, v51
    v_permlane32_swap_b32 v52, v54
    v_permlane32_swap_b32 v53, v55
    s_nop 0
    v_add_f32 v48, v48, v50
    v_add_f32 v49, v49, v51
    v_add_f32 v52, v52, v54
    v_add_f32 v53, v53, v55
    s_nop 1
    v_permlane16_swap_b32 v48, v49
    v_permlane16_swap_b32 v52, v53
    s_nop 0
    v_add_f32 v53, v52, v53
    v_add_f32 v52, v48, v49
    s_cmp_eq_u32 s62, 0
    s_cbranch_scc1 L_wm0a
    ds_write_b64 v11, v[52:53]
    s_waitcnt lgkmcnt(0)
L_wm0a:
    s_barrier
    s_cmp_lg_u32 s62, 0
    s_cbranch_scc1 L_wm1b
    ds_read_b64 v[54:55], v11
    s_lshl_b32 s64, s55, 10
    v_mov_b32 v56, 0x7fc00000
    s_waitcnt lgkmcnt(0)
    v_pk_add_f32 v[52:53], v[52:53], v[54:55]
    v_cmp_eq_u32 vcc, -1, v52
    s_nop 1
    v_cndmask_b32 v52, v52, v56, vcc
    v_cmp_eq_u32 vcc, -1, v53
    s_nop 1
    v_cndmask_b32 v53, v53, v56, vcc
    buffer_store_dwordx2 v[52:53], v10, s[32:35], s64 offen sc1
L_wm1b:
    v_and_b32 v9, 7, v3
    v_lshrrev_b32 v10, 3, v3
    v_lshlrev_b32 v10, 2, v10
    v_xor_b32 v9, v9, v10
    v_xor_b32 v9, v9, v8
    v_lshlrev_b32 v9, 4, v9
    v_lshl_add_u32 v9, v3, 8, v9
    s_lshl_b32 s64, s56, 14
    v_add_u32 v9, s64, v9
    ds_write_b128 v9, v[64:67] offset:0
    ds_write_b128 v9, v[72:75] offset:8192
    v_xor_b32 v10, 128, v9
    ds_write_b128 v10, v[68:71] offset:4096
    ds_write_b128 v10, v[76:79] offset:12288
    v_xor_b32 v10, 64, v9
    ds_write_b128 v10, v[80:83] offset:0
    ds_write_b128 v10, v[88:91] offset:8192
    v_xor_b32 v10, 192, v9
    ds_write_b128 v10, v[84:87] offset:4096
    ds_write_b128 v10, v[92:95] offset:12288
    v_xor_b32 v10, 128, v9
    ds_write_b128 v10, v[96:99] offset:0
    ds_write_b128 v10, v[104:107] offset:8192
    ds_write_b128 v9, v[100:103] offset:4096
    ds_write_b128 v9, v[108:111] offset:12288
    v_xor_b32 v10, 192, v9
    ds_write_b128 v10, v[112:115] offset:0
    ds_write_b128 v10, v[120:123] offset:8192
    v_xor_b32 v10, 64, v9
    ds_write_b128 v10, v[116:119] offset:4096
    ds_write_b128 v10, v[124:127] offset:12288
L_join:
    v_and_b32 v4, 7, v2
    v_lshrrev_b32 v3, 3, v2
    s_lshl_b32 s62, s56, 7
    v_lshl_add_u32 v7, v4, 4, s62
    v_lshl_add_u32 v12, v3, 10, v7
    v_add_u32 v11, 0x14000, v7
    s_waitcnt lgkmcnt(0)
    s_barrier
    s_mov_b32 s72, 0
    s_mov_b32 s63, 0
    buffer_load_dwordx4 v[96:99], v12, s[32:35], s63 offen sc1
    s_mov_b32 s63, 8192
    buffer_load_dwordx4 v[100:103], v12, s[32:35], s63 offen sc1
    s_mov_b32 s63, 16384
    buffer_load_dwordx4 v[104:107], v12, s[32:35], s63 offen sc1
    s_mov_b32 s63, 24576
    buffer_load_dwordx4 v[108:111], v12, s[32:35], s63 offen sc1
    s_mov_b32 s63, 32768
    buffer_load_dwordx4 v[112:115], v12, s[32:35], s63 offen sc1
    s_mov_b32 s63, 40960
    buffer_load_dwordx4 v[116:119], v12, s[32:35], s63 offen sc1
    s_mov_b32 s63, 49152
    buffer_load_dwordx4 v[120:123], v12, s[32:35], s63 offen sc1
    s_mov_b32 s63, 57344
    buffer_load_dwordx4 v[124:127], v12, s[32:35], s63 offen sc1
    s_and_b32 s62, s56, 3
    s_lshr_b32 s63, s56, 2
    s_lshl_b32 s64, s63, 3
    v_add_u32 v3, s64, v3
    v_and_b32 v5, 3, v2
    v_lshlrev_b32 v5, 2, v5
    v_xor_b32 v5, v5, v3
    v_lshlrev_b32 v5, 4, v5
    v_lshl_add_u32 v5, v4, 11, v5
    s_lshl_b32 s64, s62, 14
    v_add_u32 v5, s64, v5
    ds_read_b128 v[64:67], v5 offset:0
    v_xor_b32 v6, 16, v5
    ds_read_b128 v[68:71], v6 offset:256
    v_xor_b32 v6, 32, v5
    ds_read_b128 v[72:75], v6 offset:512
    v_xor_b32 v6, 48, v5
    ds_read_b128 v[76:79], v6 offset:768
    v_xor_b32 v6, 64, v5
    ds_read_b128 v[80:83], v6 offset:1024
    v_xor_b32 v6, 80, v5
    ds_read_b128 v[84:87], v6 offset:1280
    v_xor_b32 v6, 96, v5
    ds_read_b128 v[88:91], v6 offset:1536
    v_xor_b32 v6, 112, v5
    ds_read_b128 v[92:95], v6 offset:1792
    s_lshr_b32 s64, s62, 1
    s_lshl_b32 s64, s64, 6
    v_lshl_add_u32 v6, v3, 2, s64
    s_and_b32 s64, s62, 1
    s_lshl_b32 s65, s64, 7
    v_lshl_add_u32 v7, v4, 4, s65
    v_mov_b32 v9, 0x40000000
    v_add_u32 v8, 0, v6
    v_cmp_gt_u32 vcc, s59, v8
    v_lshl_add_u32 v13, v8, 9, v7
    s_nop 0
    v_cndmask_b32 v13, v9, v13, vcc
    v_add_u32 v8, 1, v6
    v_cmp_gt_u32 vcc, s59, v8
    v_lshl_add_u32 v14, v8, 9, v7
    s_nop 0
    v_cndmask_b32 v14, v9, v14, vcc
    v_add_u32 v8, 2, v6
    v_cmp_gt_u32 vcc, s59, v8
    v_lshl_add_u32 v15, v8, 9, v7
    s_nop 0
    v_cndmask_b32 v15, v9, v15, vcc
    v_add_u32 v8, 3, v6
    v_cmp_gt_u32 vcc, s59, v8
    v_lshl_add_u32 v16, v8, 9, v7
    s_nop 0
    v_cndmask_b32 v16, v9, v16, vcc
    s_lshl_b32 s65, s64, 9
    s_add_u32 s65, s65, 0x14000
    v_lshl_add_u32 v17, v4, 6, s65
    v_mov_b32 v28, 0xbdd2d3e8
    v_mov_b32 v29, 0xc0135761
L_gpoll:
    s_mov_b32 s68, 0
    s_waitcnt vmcnt(0)
    v_max3_u32 v3, v96, v97, v98
    v_max3_u32 v8, v112, v113, v114
    v_max3_u32 v3, v3, v99, v100
    v_max3_u32 v8, v8, v115, v116
    v_max3_u32 v3, v3, v101, v102
    v_max3_u32 v8, v8, v117, v118
    v_max3_u32 v3, v3, v103, v104
    v_max3_u32 v8, v8, v119, v120
    v_max3_u32 v3, v3, v105, v106
    v_max3_u32 v8, v8, v121, v122
    v_max3_u32 v3, v3, v107, v108
    v_max3_u32 v8, v8, v123, v124
    v_max3_u32 v3, v3, v109, v110
    v_max3_u32 v8, v8, v125, v126
    v_max3_u32 v3, v3, v111, v127
    v_max_u32 v3, v3, v8
    v_cmp_eq_u32 vcc, -1, v3
    s_cbranch_vccz L_gdone
    v_max3_u32 v3, v96, v97, v98
    v_max_u32 v3, v3, v99
    v_cmp_eq_u32 vcc, -1, v3
    s_cmp_lg_u64 vcc, 0
    s_cselect_b32 s62, 1, 0
    s_or_b32 s68, s68, s62
    v_max3_u32 v3, v100, v101, v102
    v_max_u32 v3, v3, v103
    v_cmp_eq_u32 vcc, -1, v3
    s_cmp_lg_u64 vcc, 0
    s_cselect_b32 s62, 2, 0
    s_or_b32 s68, s68, s62
    v_max3_u32 v3, v104, v105, v106
    v_max_u32 v3, v3, v107
    v_cmp_eq_u32 vcc, -1, v3
    s_cmp_lg_u64 vcc, 0
    s_cselect_b32 s62, 4, 0
    s_or_b32 s68, s68, s62
    v_max3_u32 v3, v108, v109, v110
    v_max_u32 v3, v3, v111
    v_cmp_eq_u32 vcc, -1, v3
    s_cmp_lg_u64 vcc, 0
    s_cselect_b32 s62, 8, 0
    s_or_b32 s68, s68, s62
    v_max3_u32 v3, v112, v113, v114
    v_max_u32 v3, v3, v115
    v_cmp_eq_u32 vcc, -1, v3
    s_cmp_lg_u64 vcc, 0
    s_cselect_b32 s62, 16, 0
    s_or_b32 s68, s68, s62
    v_max3_u32 v3, v116, v117, v118
    v_max_u32 v3, v3, v119
    v_cmp_eq_u32 vcc, -1, v3
    s_cmp_lg_u64 vcc, 0
    s_cselect_b32 s62, 32, 0
    s_or_b32 s68, s68, s62
    v_max3_u32 v3, v120, v121, v122
    v_max_u32 v3, v3, v123
    v_cmp_eq_u32 vcc, -1, v3
    s_cmp_lg_u64 vcc, 0
    s_cselect_b32 s62, 64, 0
    s_or_b32 s68, s68, s62
    v_max3_u32 v3, v124, v125, v126
    v_max_u32 v3, v3, v127
    v_cmp_eq_u32 vcc, -1, v3
    s_cmp_lg_u64 vcc, 0
    s_cselect_b32 s62, 128, 0
    s_or_b32 s68, s68, s62
    s_cbranch_scc0 L_gdone
    s_add_u32 s72, s72, 1
    s_cmp_ge_u32 s72, 0x40000
    s_cbranch_scc1 L_gdone
    s_bitcmp1_b32 s68, 0
    s_cbranch_scc0 L_gskip0
    s_mov_b32 s63, 0
    buffer_load_dwordx4 v[96:99], v12, s[32:35], s63 offen sc1
L_gskip0:
    s_bitcmp1_b32 s68, 1
    s_cbranch_scc0 L_gskip1
    s_mov_b32 s63, 8192
    buffer_load_dwordx4 v[100:103], v12, s[32:35], s63 offen sc1
L_gskip1:
    s_bitcmp1_b32 s68, 2
    s_cbranch_scc0 L_gskip2
    s_mov_b32 s63, 16384
    buffer_load_dwordx4 v[104:107], v12, s[32:35], s63 offen sc1
L_gskip2:
    s_bitcmp1_b32 s68, 3
    s_cbranch_scc0 L_gskip3
    s_mov_b32 s63, 24576
    buffer_load_dwordx4 v[108:111], v12, s[32:35], s63 offen sc1
L_gskip3:
    s_bitcmp1_b32 s68, 4
    s_cbranch_scc0 L_gskip4
    s_mov_b32 s63, 32768
    buffer_load_dwordx4 v[112:115], v12, s[32:35], s63 offen sc1
L_gskip4:
    s_bitcmp1_b32 s68, 5
    s_cbranch_scc0 L_gskip5
    s_mov_b32 s63, 40960
    buffer_load_dwordx4 v[116:119], v12, s[32:35], s63 offen sc1
L_gskip5:
    s_bitcmp1_b32 s68, 6
    s_cbranch_scc0 L_gskip6
    s_mov_b32 s63, 49152
    buffer_load_dwordx4 v[120:123], v12, s[32:35], s63 offen sc1
L_gskip6:
    s_bitcmp1_b32 s68, 7
    s_cbranch_scc0 L_gskip7
    s_mov_b32 s63, 57344
    buffer_load_dwordx4 v[124:127], v12, s[32:35], s63 offen sc1
L_gskip7:
    s_branch L_gpoll
L_gdone:
    v_pk_add_f32 v[96:97], v[96:97], v[112:113]
    v_pk_add_f32 v[98:99], v[98:99], v[114:115]
    v_pk_add_f32 v[100:101], v[100:101], v[116:117]
    v_pk_add_f32 v[102:103], v[102:103], v[118:119]
    v_pk_add_f32 v[104:105], v[104:105], v[120:121]
    v_pk_add_f32 v[106:107], v[106:107], v[122:123]
    v_pk_add_f32 v[108:109], v[108:109], v[124:125]
    v_pk_add_f32 v[110:111], v[110:111], v[126:127]
    v_pk_add_f32 v[96:97], v[96:97], v[104:105]
    v_pk_add_f32 v[98:99], v[98:99], v[106:107]
    v_pk_add_f32 v[100:101], v[100:101], v[108:109]
    v_pk_add_f32 v[102:103], v[102:103], v[110:111]
    v_pk_add_f32 v[96:97], v[96:97], v[100:101]
    v_pk_add_f32 v[98:99], v[98:99], v[102:103]
    s_mov_b32 s62, 0x390316a0
    s_mov_b32 s63, 0x3727c5ac
    v_add_f32_dpp v100, v96, v96 row_ror:8 row_mask:0xf bank_mask:0xf
    v_add_f32_dpp v101, v97, v97 row_ror:8 row_mask:0xf bank_mask:0xf
    v_add_f32_dpp v102, v98, v98 row_ror:8 row_mask:0xf bank_mask:0xf
    v_add_f32_dpp v103, v99, v99 row_ror:8 row_mask:0xf bank_mask:0xf
    v_lshlrev_b32 v18, 16, v30
    v_and_b32 v19, 0xffff0000, v30
    v_mov_b32 v96, v100
    v_mov_b32 v97, v101
    v_mov_b32 v98, v102
    v_mov_b32 v99, v103
    v_lshlrev_b32 v20, 16, v31
    v_and_b32 v21, 0xffff0000, v31
    v_permlane16_swap_b32 v96, v100
    v_permlane16_swap_b32 v97, v101
    v_permlane16_swap_b32 v98, v102
    v_permlane16_swap_b32 v99, v103
    s_nop 0
    v_pk_add_f32 v[96:97], v[96:97], v[100:101]
    v_pk_add_f32 v[98:99], v[98:99], v[102:103]
    v_mov_b32 v100, v96
    v_mov_b32 v101, v97
    v_mov_b32 v102, v98
    v_mov_b32 v103, v99
    s_nop 1
    v_permlane32_swap_b32 v96, v100
    v_permlane32_swap_b32 v97, v101
    v_permlane32_swap_b32 v98, v102
    v_permlane32_swap_b32 v99, v103
    s_nop 0
    v_pk_add_f32 v[96:97], v[96:97], v[100:101]
    v_pk_add_f32 v[98:99], v[98:99], v[102:103]
    v_pk_mul_f32 v[96:97], v[96:97], s[62:63] op_sel_hi:[1,0]
    v_pk_mul_f32 v[98:99], v[98:99], s[62:63] op_sel_hi:[1,0]
    v_fma_f32 v97, -v96, v96, v97
    v_fma_f32 v99, -v98, v98, v99
    v_max_f32 v97, 0, v97
    v_max_f32 v99, 0, v99
    v_add_f32 v97, s63, v97
    v_add_f32 v99, s63, v99
    v_rsq_f32 v97, v97
    v_rsq_f32 v99, v99
    s_nop 0
    v_mul_f32 v22, v18, v97
    v_mul_f32 v24, v19, v99
    v_fma_f32 v23, -v96, v22, v20
    v_fma_f32 v25, -v98, v24, v21
    s_mov_b64 exec, 0xff
    ds_write_b128 v11, v[22:25]
    s_mov_b64 exec, -1
    s_waitcnt lgkmcnt(0)
    s_barrier
    ds_read_b128 v[32:35], v17 offset:0
    ds_read_b128 v[36:39], v17 offset:16
    ds_read_b128 v[40:43], v17 offset:32
    ds_read_b128 v[44:47], v17 offset:48
    s_waitcnt lgkmcnt(0)
    v_pk_fma_f32 v[64:65], v[64:65], v[32:33], v[32:33] op_sel:[0,0,1] op_sel_hi:[1,0,1]
    v_pk_fma_f32 v[68:69], v[68:69], v[34:35], v[34:35] op_sel:[0,0,1] op_sel_hi:[1,0,1]
    v_pk_fma_f32 v[72:73], v[72:73], v[36:37], v[36:37] op_sel:[0,0,1] op_sel_hi:[1,0,1]
    v_pk_fma_f32 v[76:77], v[76:77], v[38:39], v[38:39] op_sel:[0,0,1] op_sel_hi:[1,0,1]
    v_pk_fma_f32 v[80:81], v[80:81], v[40:41], v[40:41] op_sel:[0,0,1] op_sel_hi:[1,0,1]
    v_pk_fma_f32 v[84:85], v[84:85], v[42:43], v[42:43] op_sel:[0,0,1] op_sel_hi:[1,0,1]
    v_pk_fma_f32 v[88:89], v[88:89], v[44:45], v[44:45] op_sel:[0,0,1] op_sel_hi:[1,0,1]
    v_pk_fma_f32 v[92:93], v[92:93], v[46:47], v[46:47] op_sel:[0,0,1] op_sel_hi:[1,0,1]
    v_pk_mul_f32 v[96:97], v[64:65], v[64:65]
    v_pk_mul_f32 v[98:99], v[68:69], v[68:69]
    v_pk_mul_f32 v[100:101], v[72:73], v[72:73]
    v_pk_mul_f32 v[102:103], v[76:77], v[76:77]
    v_pk_mul_f32 v[104:105], v[80:81], v[80:81]
    v_pk_mul_f32 v[106:107], v[84:85], v[84:85]
    v_pk_mul_f32 v[108:109], v[88:89], v[88:89]
    v_pk_mul_f32 v[110:111], v[92:93], v[92:93]
    v_pk_fma_f32 v[96:97], v[96:97], v[28:29], v[28:29] op_sel:[0,0,1] op_sel_hi:[1,0,1]
    v_pk_fma_f32 v[98:99], v[98:99], v[28:29], v[28:29] op_sel:[0,0,1] op_sel_hi:[1,0,1]
    v_pk_fma_f32 v[100:101], v[100:101], v[28:29], v[28:29] op_sel:[0,0,1] op_sel_hi:[1,0,1]
    v_pk_fma_f32 v[102:103], v[102:103], v[28:29], v[28:29] op_sel:[0,0,1] op_sel_hi:[1,0,1]
    v_pk_fma_f32 v[104:105], v[104:105], v[28:29], v[28:29] op_sel:[0,0,1] op_sel_hi:[1,0,1]
    v_pk_fma_f32 v[106:107], v[106:107], v[28:29], v[28:29] op_sel:[0,0,1] op_sel_hi:[1,0,1]
    v_pk_fma_f32 v[108:109], v[108:109], v[28:29], v[28:29] op_sel:[0,0,1] op_sel_hi:[1,0,1]
    v_pk_fma_f32 v[110:111], v[110:111], v[28:29], v[28:29] op_sel:[0,0,1] op_sel_hi:[1,0,1]
    v_pk_mul_f32 v[96:97], v[96:97], v[64:65]
    v_pk_mul_f32 v[98:99], v[98:99], v[68:69]
    v_pk_mul_f32 v[100:101], v[100:101], v[72:73]
    v_pk_mul_f32 v[102:103], v[102:103], v[76:77]
    v_pk_mul_f32 v[104:105], v[104:105], v[80:81]
    v_pk_mul_f32 v[106:107], v[106:107], v[84:85]
    v_pk_mul_f32 v[108:109], v[108:109], v[88:89]
    v_pk_mul_f32 v[110:111], v[110:111], v[92:93]
    v_exp_f32 v96, v96
    v_exp_f32 v97, v97
    v_exp_f32 v98, v98
    v_exp_f32 v99, v99
    v_exp_f32 v100, v100
    v_exp_f32 v101, v101
    v_exp_f32 v102, v102
    v_exp_f32 v103, v103
    v_exp_f32 v104, v104
    v_exp_f32 v105, v105
    v_exp_f32 v106, v106
    v_exp_f32 v107, v107
    v_exp_f32 v108, v108
    v_exp_f32 v109, v109
    v_exp_f32 v110, v110
    v_exp_f32 v111, v111
    v_pk_add_f32 v[96:97], v[96:97], 1.0 op_sel_hi:[1,0]
    v_pk_add_f32 v[98:99], v[98:99], 1.0 op_sel_hi:[1,0]
    v_pk_add_f32 v[100:101], v[100:101], 1.0 op_sel_hi:[1,0]
    v_pk_add_f32 v[102:103], v[102:103], 1.0 op_sel_hi:[1,0]
    v_pk_add_f32 v[104:105], v[104:105], 1.0 op_sel_hi:[1,0]
    v_pk_add_f32 v[106:107], v[106:107], 1.0 op_sel_hi:[1,0]
    v_pk_add_f32 v[108:109], v[108:109], 1.0 op_sel_hi:[1,0]
    v_pk_add_f32 v[110:111], v[110:111], 1.0 op_sel_hi:[1,0]
    v_rcp_f32 v96, v96
    v_rcp_f32 v97, v97
    v_rcp_f32 v98, v98
    v_rcp_f32 v99, v99
    v_rcp_f32 v100, v100
    v_rcp_f32 v101, v101
    v_rcp_f32 v102, v102
    v_rcp_f32 v103, v103
    v_rcp_f32 v104, v104
    v_rcp_f32 v105, v105
    v_rcp_f32 v106, v106
    v_rcp_f32 v107, v107
    v_rcp_f32 v108, v108
    v_rcp_f32 v109, v109
    v_rcp_f32 v110, v110
    v_rcp_f32 v111, v111
    v_pk_mul_f32 v[64:65], v[96:97], v[64:65]
    v_pk_mul_f32 v[68:69], v[98:99], v[68:69]
    v_pk_mul_f32 v[72:73], v[100:101], v[72:73]
    v_pk_mul_f32 v[76:77], v[102:103], v[76:77]
    v_pk_mul_f32 v[80:81], v[104:105], v[80:81]
    v_pk_mul_f32 v[84:85], v[106:107], v[84:85]
    v_pk_mul_f32 v[88:89], v[108:109], v[88:89]
    v_pk_mul_f32 v[92:93], v[110:111], v[92:93]
    v_cvt_pk_bf16_f32 v112, v64, v68
    v_cvt_pk_bf16_f32 v113, v72, v76
    v_cvt_pk_bf16_f32 v114, v80, v84
    v_cvt_pk_bf16_f32 v115, v88, v92
    buffer_store_dwordx4 v[112:115], v13, s[28:31], s58 offen nt
    v_cvt_pk_bf16_f32 v116, v65, v69
    v_cvt_pk_bf16_f32 v117, v73, v77
    v_cvt_pk_bf16_f32 v118, v81, v85
    v_cvt_pk_bf16_f32 v119, v89, v93
    buffer_store_dwordx4 v[116:119], v14, s[28:31], s58 offen nt
    v_pk_fma_f32 v[66:67], v[66:67], v[32:33], v[32:33] op_sel:[0,0,1] op_sel_hi:[1,0,1]
    v_pk_fma_f32 v[70:71], v[70:71], v[34:35], v[34:35] op_sel:[0,0,1] op_sel_hi:[1,0,1]
    v_pk_fma_f32 v[74:75], v[74:75], v[36:37], v[36:37] op_sel:[0,0,1] op_sel_hi:[1,0,1]
    v_pk_fma_f32 v[78:79], v[78:79], v[38:39], v[38:39] op_sel:[0,0,1] op_sel_hi:[1,0,1]
    v_pk_fma_f32 v[82:83], v[82:83], v[40:41], v[40:41] op_sel:[0,0,1] op_sel_hi:[1,0,1]
    v_pk_fma_f32 v[86:87], v[86:87], v[42:43], v[42:43] op_sel:[0,0,1] op_sel_hi:[1,0,1]
    v_pk_fma_f32 v[90:91], v[90:91], v[44:45], v[44:45] op_sel:[0,0,1] op_sel_hi:[1,0,1]
    v_pk_fma_f32 v[94:95], v[94:95], v[46:47], v[46:47] op_sel:[0,0,1] op_sel_hi:[1,0,1]
    v_pk_mul_f32 v[96:97], v[66:67], v[66:67]
    v_pk_mul_f32 v[98:99], v[70:71], v[70:71]
    v_pk_mul_f32 v[100:101], v[74:75], v[74:75]
    v_pk_mul_f32 v[102:103], v[78:79], v[78:79]
    v_pk_mul_f32 v[104:105], v[82:83], v[82:83]
    v_pk_mul_f32 v[106:107], v[86:87], v[86:87]
    v_pk_mul_f32 v[108:109], v[90:91], v[90:91]
    v_pk_mul_f32 v[110:111], v[94:95], v[94:95]
    v_pk_fma_f32 v[96:97], v[96:97], v[28:29], v[28:29] op_sel:[0,0,1] op_sel_hi:[1,0,1]
    v_pk_fma_f32 v[98:99], v[98:99], v[28:29], v[28:29] op_sel:[0,0,1] op_sel_hi:[1,0,1]
    v_pk_fma_f32 v[100:101], v[100:101], v[28:29], v[28:29] op_sel:[0,0,1] op_sel_hi:[1,0,1]
    v_pk_fma_f32 v[102:103], v[102:103], v[28:29], v[28:29] op_sel:[0,0,1] op_sel_hi:[1,0,1]
    v_pk_fma_f32 v[104:105], v[104:105], v[28:29], v[28:29] op_sel:[0,0,1] op_sel_hi:[1,0,1]
    v_pk_fma_f32 v[106:107], v[106:107], v[28:29], v[28:29] op_sel:[0,0,1] op_sel_hi:[1,0,1]
    v_pk_fma_f32 v[108:109], v[108:109], v[28:29], v[28:29] op_sel:[0,0,1] op_sel_hi:[1,0,1]
    v_pk_fma_f32 v[110:111], v[110:111], v[28:29], v[28:29] op_sel:[0,0,1] op_sel_hi:[1,0,1]
    v_pk_mul_f32 v[96:97], v[96:97], v[66:67]
    v_pk_mul_f32 v[98:99], v[98:99], v[70:71]
    v_pk_mul_f32 v[100:101], v[100:101], v[74:75]
    v_pk_mul_f32 v[102:103], v[102:103], v[78:79]
    v_pk_mul_f32 v[104:105], v[104:105], v[82:83]
    v_pk_mul_f32 v[106:107], v[106:107], v[86:87]
    v_pk_mul_f32 v[108:109], v[108:109], v[90:91]
    v_pk_mul_f32 v[110:111], v[110:111], v[94:95]
    v_exp_f32 v96, v96
    v_exp_f32 v97, v97
    v_exp_f32 v98, v98
    v_exp_f32 v99, v99
    v_exp_f32 v100, v100
    v_exp_f32 v101, v101
    v_exp_f32 v102, v102
    v_exp_f32 v103, v103
    v_exp_f32 v104, v104
    v_exp_f32 v105, v105
    v_exp_f32 v106, v106
    v_exp_f32 v107, v107
    v_exp_f32 v108, v108
    v_exp_f32 v109, v109
    v_exp_f32 v110, v110
    v_exp_f32 v111, v111
    v_pk_add_f32 v[96:97], v[96:97], 1.0 op_sel_hi:[1,0]
    v_pk_add_f32 v[98:99], v[98:99], 1.0 op_sel_hi:[1,0]
    v_pk_add_f32 v[100:101], v[100:101], 1.0 op_sel_hi:[1,0]
    v_pk_add_f32 v[102:103], v[102:103], 1.0 op_sel_hi:[1,0]
    v_pk_add_f32 v[104:105], v[104:105], 1.0 op_sel_hi:[1,0]
    v_pk_add_f32 v[106:107], v[106:107], 1.0 op_sel_hi:[1,0]
    v_pk_add_f32 v[108:109], v[108:109], 1.0 op_sel_hi:[1,0]
    v_pk_add_f32 v[110:111], v[110:111], 1.0 op_sel_hi:[1,0]
    v_rcp_f32 v96, v96
    v_rcp_f32 v97, v97
    v_rcp_f32 v98, v98
    v_rcp_f32 v99, v99
    v_rcp_f32 v100, v100
    v_rcp_f32 v101, v101
    v_rcp_f32 v102, v102
    v_rcp_f32 v103, v103
    v_rcp_f32 v104, v104
    v_rcp_f32 v105, v105
    v_rcp_f32 v106, v106
    v_rcp_f32 v107, v107
    v_rcp_f32 v108, v108
    v_rcp_f32 v109, v109
    v_rcp_f32 v110, v110
    v_rcp_f32 v111, v111
    v_pk_mul_f32 v[66:67], v[96:97], v[66:67]
    v_pk_mul_f32 v[70:71], v[98:99], v[70:71]
    v_pk_mul_f32 v[74:75], v[100:101], v[74:75]
    v_pk_mul_f32 v[78:79], v[102:103], v[78:79]
    v_pk_mul_f32 v[82:83], v[104:105], v[82:83]
    v_pk_mul_f32 v[86:87], v[106:107], v[86:87]
    v_pk_mul_f32 v[90:91], v[108:109], v[90:91]
    v_pk_mul_f32 v[94:95], v[110:111], v[94:95]
    v_cvt_pk_bf16_f32 v120, v66, v70
    v_cvt_pk_bf16_f32 v121, v74, v78
    v_cvt_pk_bf16_f32 v122, v82, v86
    v_cvt_pk_bf16_f32 v123, v90, v94
    buffer_store_dwordx4 v[120:123], v15, s[28:31], s58 offen nt
    v_cvt_pk_bf16_f32 v124, v67, v71
    v_cvt_pk_bf16_f32 v125, v75, v79
    v_cvt_pk_bf16_f32 v126, v83, v87
    v_cvt_pk_bf16_f32 v127, v91, v95
    buffer_store_dwordx4 v[124:127], v16, s[28:31], s58 offen nt
L_end:
    s_endpgm
L_armer:
    s_lshl_b32 s60, s53, 1
    s_add_u32 s60, s60, s52
    v_lshlrev_b32 v3, 4, v0
    v_mov_b32 v4, -1
    v_mov_b32 v5, -1
    v_mov_b32 v6, -1
    v_mov_b32 v7, -1
    s_waitcnt lgkmcnt(0)
    s_mov_b32 s36, s14
    s_and_b32 s37, s15, 0xffff
    s_mov_b32 s38, 256
    s_mov_b32 s39, 0x00020000
    s_lshl_b32 s62, s60, 16
    s_add_u32 s32, s16, s62
    s_addc_u32 s33, s17, 0
    s_and_b32 s33, s33, 0xffff
    s_mov_b32 s34, 64512
    s_mov_b32 s35, 0x00020000
    s_mov_b32 s63, 0
    buffer_store_dwordx4 v[4:7], v3, s[32:35], s63 offen sc1
    s_mov_b32 s63, 8192
    buffer_store_dwordx4 v[4:7], v3, s[32:35], s63 offen sc1
    s_mov_b32 s63, 16384
    buffer_store_dwordx4 v[4:7], v3, s[32:35], s63 offen sc1
    s_mov_b32 s63, 24576
    buffer_store_dwordx4 v[4:7], v3, s[32:35], s63 offen sc1
    s_mov_b32 s63, 32768
    buffer_store_dwordx4 v[4:7], v3, s[32:35], s63 offen sc1
    s_mov_b32 s63, 40960
    buffer_store_dwordx4 v[4:7], v3, s[32:35], s63 offen sc1
    s_mov_b32 s63, 49152
    buffer_store_dwordx4 v[4:7], v3, s[32:35], s63 offen sc1
    s_mov_b32 s63, 57344
    buffer_store_dwordx4 v[4:7], v3, s[32:35], s63 offen sc1
    s_waitcnt vmcnt(0)
    s_barrier
    v_cmp_eq_u32 vcc, 0, v0
    s_lshl_b32 s62, s60, 6
    v_mov_b32 v8, s62
    v_mov_b32 v9, 1
    s_and_saveexec_b64 s[4:5], vcc
    s_cbranch_execz L_armend
    buffer_store_dword v9, v8, s[36:39], 0 offen sc1
L_armend:
    s_endpgm
L_codeend:
.section .rodata,"a"
.p2align 6
.amdhsa_kernel standalone__self_sup_conv_stem_wavlm__speech_kernel
  .amdhsa_next_free_vgpr 160
  .amdhsa_next_free_sgpr 96
  .amdhsa_accum_offset 160
  .amdhsa_group_segment_fixed_size 0
  .amdhsa_kernarg_size 56
  .amdhsa_user_sgpr_count 2
  .amdhsa_user_sgpr_kernarg_segment_ptr 1
  .amdhsa_system_sgpr_workgroup_id_x 1
  .amdhsa_float_denorm_mode_32 3
.end_amdhsa_kernel
```
